```python
import torch

def _softmax(x, axis=-1):
    return torch.softmax(x, dim=axis)
def _gelu(x):
    return torch.nn.functional.gelu(x, approximate="tanh")
def _silu(x):
    return torch.nn.functional.silu(x)
def _sigmoid(x):
    return torch.sigmoid(x)
def _layernorm(x, axis=-1, eps=1e-5):
    m = x.mean(dim=axis, keepdim=True)
    v = x.var(dim=axis, keepdim=True, unbiased=False)
    return (x - m) / torch.sqrt(v + eps)
def _scatter_add(tgt, idx, src, axis=0):
    return tgt.clone().index_add_(axis, idx, src)
def _segment_sum(src, seg, n):
    out = torch.zeros((n,) + src.shape[1:], dtype=src.dtype)
    return out.index_add_(0, seg, src)
def _pad(x, pw):
    flat = tuple(v for pair in reversed(pw) for v in pair)
    return torch.nn.functional.pad(x, flat)

kernel_name = 'standalone__paged_block_table_kv_pagedattention__sampling'

def setup_inputs():

    _w = (lambda a: (lambda t: t.to(torch.bfloat16) if t.is_floating_point() else t)(torch.as_tensor(a)))
    B, Hq, Hkv, Sq, Skv, D = 32, 32, 8, 8, 2048, 128
    bs = 16
    nbps = max(1, Skv // bs)
    num_phys = B * nbps + 4
    bt = torch.randperm(num_phys)[: B * nbps].reshape(B, nbps).to(torch.int64)
    cl = (nbps * bs - (torch.arange(1, B + 1, dtype=torch.int64) * 2654435761) % max(1, nbps * bs // 2)).to(torch.int64)
    return {
        "q": _w((lambda *s: torch.randn(*s, dtype=torch.bfloat16) * 0.8)(B, Hq, Sq, D)),
        "k_cache": _w((lambda *s: torch.randn(*s, dtype=torch.bfloat16) * 0.8)(num_phys, bs, Hkv, D)),
        "v_cache": _w((lambda *s: torch.randn(*s, dtype=torch.bfloat16) * 0.05)(num_phys, bs, Hkv, D)),
        "block_table": _w(bt),
        "context_lens": _w(cl),
    }

def reference(q, k_cache, v_cache, block_table, context_lens):
    B, Hq, Sq, D = q.shape
    bs = k_cache.shape[1]
    Hkv = k_cache.shape[2]
    nbps = block_table.shape[1]
    Skv = nbps * bs
    bt = block_table.reshape(-1)
    k = (lambda x, *d: x.permute(*d))(k_cache[bt].reshape(B, Skv, Hkv, D), 0, 2, 1, 3)
    v = (lambda x, *d: x.permute(*d))(v_cache[bt].reshape(B, Skv, Hkv, D), 0, 2, 1, 3)
    g = Hq // Hkv
    qg = q.reshape(B, Hkv, g, Sq, D)
    scores = torch.einsum("bhgqd,bhkd->bhgqk", qg, k) * (D ** -0.5)
    pos = torch.arange(Skv)
    msk = pos[None, :] < context_lens[:, None]
    scores = torch.where(msk[:, None, None, None, :], scores, -1e9)
    p = _softmax(scores, axis=-1)
    out = torch.einsum("bhgqk,bhkd->bhgqd", p, v)
    return out.reshape(B, Hq, Sq, D)
```

```asm
; @launch grid=(256,1,1) block=(384,1,1) lds=162560
.amdgcn_target "amdgcn-amd-amdhsa--gfx950"
.text
.globl standalone__paged_block_table_kv_pagedattention__sampling_kernel
.p2align 8
.type standalone__paged_block_table_kv_pagedattention__sampling_kernel,@function
standalone__paged_block_table_kv_pagedattention__sampling_kernel:
s_load_dwordx16 s[4:19], s[0:1], 0
s_cmpk_ge_u32 s2, 256
s_cbranch_scc1 L_end
s_getpc_b64 s[28:29]
L_pc0:
v_subrev_u32 v2, 64, v0
v_lshlrev_b32 v2, 7, v2
v_cmp_gt_u32 vcc, L_end-L_pc0, v2
s_and_saveexec_b64 s[36:37], vcc
s_cbranch_execz L_nocpf
global_load_dword v39, v2, s[28:29]
L_nocpf:
s_mov_b64 exec, -1
s_lshr_b32 s32, s2, 3
v_readfirstlane_b32 s34, v0
v_and_b32 v0, 63, v0
s_lshl_b32 s35, s32, 9
v_lshlrev_b32 v1, 3, v0
s_lshr_b32 s34, s34, 6
s_cbranch_scc1 L_notloader
v_add_u32 v1, s35, v1
s_lshl_b32 s35, s32, 2
s_waitcnt lgkmcnt(0)
global_load_dwordx2 v[24:25], v1, s[10:11]
s_load_dword s37, s[12:13], s35
s_setprio 3
s_lshl_b32 s38, s32, 22
s_lshl_b32 s39, s2, 8
s_add_u32 s38, s38, s39
v_and_b32 v30, 1, v0
v_lshlrev_b32 v30, 21, v30
v_add_u32 v30, s38, v30
global_load_dword v31, v30, s[6:7] nt
s_mov_b32 s66, 0x2875d74e
s_mov_b32 s67, 0x28b2c74e
s_lshl_b32 s33, s32, 1
s_lshr_b64 s[38:39], s[66:67], s33
s_and_b32 s38, s38, 3
s_and_b32 s33, s32, 4
s_add_u32 s33, s33, s38
s_add_u32 s33, s33, s2
s_and_b32 s33, s33, 7
v_lshrrev_b32 v4, 4, v0
v_and_b32 v5, 15, v0
v_lshlrev_b32 v16, 2, v4
v_xor_b32 v16, v5, v16
v_lshlrev_b32 v16, 4, v16
v_lshl_add_u32 v12, v4, 8, v16
v_xor_b32 v13, 16, v12
v_xor_b32 v14, 32, v12
v_xor_b32 v15, 48, v12
s_lshl_b32 s52, s32, 3
s_add_u32 s52, s52, s33
s_lshl_b32 s52, s52, 13
s_add_u32 s53, s52, 4096
s_mov_b32 s26, 2097152
s_mov_b32 s27, 0x20000
s_mov_b32 m0, 150528
s_mov_b32 s24, s4
s_mov_b32 s25, s5
buffer_load_dwordx4 v12, s[24:27], s52 offen offset:0 nt lds
buffer_load_dwordx4 v13, s[24:27], s52 offen offset:1024 nt lds
buffer_load_dwordx4 v14, s[24:27], s52 offen offset:2048 nt lds
buffer_load_dwordx4 v15, s[24:27], s52 offen offset:3072 nt lds
s_add_u32 m0, m0, 4096
s_nop 0
buffer_load_dwordx4 v12, s[24:27], s53 offen offset:0 nt lds
buffer_load_dwordx4 v13, s[24:27], s53 offen offset:1024 nt lds
buffer_load_dwordx4 v14, s[24:27], s53 offen offset:2048 nt lds
buffer_load_dwordx4 v15, s[24:27], s53 offen offset:3072 nt lds
s_mov_b32 s16, s6
s_mov_b32 s17, s7
s_mov_b32 s18, 134348800
s_mov_b32 s19, 0x20000
s_mov_b32 s20, s6
s_mov_b32 s21, s7
s_mov_b32 s22, 134348800
s_mov_b32 s23, 0x20000
v_lshl_add_u32 v8, v4, 11, v16
v_xor_b32 v9, 16, v8
v_add_u32 v9, 7168, v9
v_xor_b32 v10, 32, v8
v_add_u32 v10, 14336, v10
v_xor_b32 v11, 48, v8
v_add_u32 v11, 21504, v11
v_lshlrev_b32 v21, 5, v0
s_lshl_b32 s36, s33, 8
s_mov_b32 s59, 134348800
s_mov_b32 s42, 0
s_mov_b32 s56, -1
s_mov_b32 s54, 128
s_mov_b32 s49, 0
v_mov_b32 v32, 158720
s_waitcnt lgkmcnt(0)
s_cmp_gt_i32 s37, 0
s_cselect_b32 s37, s37, 2048
s_min_i32 s37, s37, 2048
v_sub_u32 v21, s37, v21
s_sub_u32 s48, s37, 1
s_lshr_b32 s48, s48, 5
v_med3_i32 v22, v21, 0, 16
v_subrev_u32 v21, 16, v21
v_med3_i32 v23, v21, 0, 16
s_and_b32 s41, s48, 3
s_add_u32 s41, s41, 1
s_min_u32 s50, s41, 3
s_mov_b32 s46, s41
s_mul_i32 s39, s37, 9
s_lshr_b32 s39, s39, 1
s_sub_i32 s39, s39, 1280
s_max_i32 s39, s39, 5120
v_mov_b32 v33, s39
s_waitcnt vmcnt(9)
v_lshlrev_b32 v2, 15, v24
v_lshlrev_b32 v3, 15, v25
v_lshl_add_u32 v4, v22, 11, v2
v_lshl_add_u32 v5, v23, 11, v3
v_add_u32 v2, s36, v2
v_min_u32 v4, s59, v4
v_add_u32 v3, s36, v3
v_min_u32 v5, s59, v5
ds_write_b32 v32, v33
L_ld32:
v_readlane_b32 s52, v2, s48
v_readlane_b32 s18, v4, s48
v_readlane_b32 s53, v3, s48
v_readlane_b32 s22, v5, s48
s_mov_b32 m0, s49
s_sub_u32 s48, s48, 1
s_add_u32 s49, s49, 8192
s_sub_i32 s51, s42, 3
s_add_u32 s42, s42, 1
s_waitcnt vmcnt(31)
buffer_load_dwordx4 v8, s[16:19], s52 offen offset:0 nt lds
s_waitcnt vmcnt(31)
buffer_load_dwordx4 v9, s[16:19], s52 offen offset:1024 nt lds
s_waitcnt vmcnt(31)
buffer_load_dwordx4 v10, s[16:19], s52 offen offset:2048 nt lds
s_waitcnt vmcnt(31)
buffer_load_dwordx4 v11, s[16:19], s52 offen offset:3072 nt lds
s_add_u32 m0, m0, 4096
s_waitcnt vmcnt(31)
buffer_load_dwordx4 v8, s[20:23], s53 offen offset:0 nt lds
s_waitcnt vmcnt(31)
buffer_load_dwordx4 v9, s[20:23], s53 offen offset:1024 nt lds
ds_read_b32 v33, v32
s_waitcnt vmcnt(31)
buffer_load_dwordx4 v10, s[20:23], s53 offen offset:2048 nt lds
s_cmp_lt_i32 s51, s46
s_waitcnt vmcnt(31)
s_cbranch_scc1 L_ld32_np
s_barrier
s_add_u32 s43, s43, s44
s_add_u32 s51, s51, 3
s_max_i32 s46, s43, s51
s_cmp_eq_u32 s43, s45
s_cselect_b32 s44, s41, 4
L_ld32_np:
buffer_load_dwordx4 v11, s[20:23], s53 offen offset:3072 nt lds
s_sub_u32 s50, s50, 1
s_cmp_lg_u32 s50, 0
s_cbranch_scc1 L_ld32
s_cmp_ge_i32 s56, 0
s_cbranch_scc1 L_next
s_add_u32 s43, s48, 1
v_lshlrev_b32 v38, 2, v0
v_mov_b32 v39, 0
v_add_u32 v38, 158976, v38
v_lshrrev_b32 v34, 6, v24
ds_write_b32 v38, v39
v_lshrrev_b32 v35, 6, v25
v_min_u32 v34, 63, v34
v_min_u32 v35, 63, v35
v_cmp_gt_i32 vcc, s43, v0
v_lshlrev_b32 v34, 2, v34
v_lshlrev_b32 v35, 2, v35
v_cndmask_b32 v41, 0, 1, vcc
v_add_u32 v39, 158976, v34
v_add_u32 v40, 158976, v35
ds_add_rtn_u32 v36, v39, v41
ds_add_rtn_u32 v37, v40, v41
ds_read_b32 v39, v38
s_waitcnt lgkmcnt(0)
s_nop 0
v_add_u32_dpp v40, v39, v39 row_shr:1 row_mask:0xf bank_mask:0xf bound_ctrl:0
s_nop 1
v_add_u32_dpp v40, v40, v40 row_shr:2 row_mask:0xf bank_mask:0xf bound_ctrl:0
s_nop 1
v_add_u32_dpp v40, v40, v40 row_shr:4 row_mask:0xf bank_mask:0xf bound_ctrl:0
s_nop 1
v_add_u32_dpp v40, v40, v40 row_shr:8 row_mask:0xf bank_mask:0xf bound_ctrl:0
s_nop 1
v_add_u32_dpp v40, v40, v40 row_bcast:15 row_mask:0xa bank_mask:0xf
s_nop 1
v_add_u32_dpp v40, v40, v40 row_bcast:31 row_mask:0xc bank_mask:0xf
v_sub_u32 v40, v40, v39
ds_bpermute_b32 v34, v34, v40
ds_bpermute_b32 v35, v35, v40
v_lshlrev_b32 v38, 1, v0
v_add_u32 v39, 1, v38
s_waitcnt lgkmcnt(0)
v_add_u32 v34, v34, v36
v_add_u32 v35, v35, v37
v_cndmask_b32 v34, v38, v34, vcc
v_cndmask_b32 v35, v39, v35, vcc
v_lshlrev_b32 v34, 2, v34
v_lshlrev_b32 v35, 2, v35
v_add_u32 v34, 159232, v34
v_add_u32 v35, 159232, v35
ds_write_b32 v34, v24
ds_write_b32 v35, v25
v_lshlrev_b32 v1, 3, v0
v_add_u32 v1, 159232, v1
ds_read_b64 v[2:3], v1
s_add_u32 s55, s48, s42
s_add_u32 s45, s55, 1
s_mov_b32 s43, s41
s_cmp_eq_u32 s41, s45
s_cselect_b32 s44, 0, 4
s_cselect_b32 s58, 1, 0
s_lshl_b32 s47, s45, 1
s_mov_b32 s56, 0
s_waitcnt lgkmcnt(0)
v_lshlrev_b32 v2, 15, v2
v_lshlrev_b32 v3, 15, v3
v_lshl_add_u32 v4, v22, 11, v2
v_lshl_add_u32 v5, v23, 11, v3
v_add_u32 v2, s36, v2
v_min_u32 v4, s59, v4
v_add_u32 v3, s36, v3
v_min_u32 v5, s59, v5
s_sub_u32 s50, s41, s42
s_cmp_lg_u32 s50, 0
s_cbranch_scc1 L_ld32
L_next:
s_waitcnt lgkmcnt(0)
v_readfirstlane_b32 s39, v33
s_add_u32 s56, s56, 1
s_mov_b32 s50, 4
s_cmp_ge_i32 s48, 0
s_cbranch_scc1 L_area
s_cmp_lt_i32 s55, 0
s_cbranch_scc1 L_drain
s_mov_b32 s16, s8
s_mov_b32 s17, s9
s_mov_b32 s20, s8
s_mov_b32 s21, s9
s_mov_b32 s48, s55
s_mov_b32 s55, -1
s_mov_b32 s50, s41
s_add_u32 s56, s56, s58
L_area:
s_and_b32 s49, s56, 3
s_lshl_b32 s49, s49, 15
L_disp:
s_add_u32 s54, s54, s39
s_lshr_b32 s57, s54, 8
s_and_b32 s54, s54, 511
s_cmp_ge_u32 s57, 22
s_cbranch_scc1 L_disp22_34
s_cmp_ge_u32 s57, 14
s_cbranch_scc1 L_disp14_20
s_cmp_ge_u32 s57, 10
s_cbranch_scc1 L_disp10_12
s_branch L_ld8
L_disp10_12:
s_cmp_ge_u32 s57, 12
s_cbranch_scc1 L_ld12
s_branch L_ld10
L_disp14_20:
s_cmp_ge_u32 s57, 18
s_cbranch_scc1 L_disp18_20
s_cmp_ge_u32 s57, 16
s_cbranch_scc1 L_ld16
s_branch L_ld14
L_disp18_20:
s_cmp_ge_u32 s57, 20
s_cbranch_scc1 L_ld20
s_branch L_ld18
L_disp22_34:
s_cmp_ge_u32 s57, 28
s_cbranch_scc1 L_disp28_34
s_cmp_ge_u32 s57, 24
s_cbranch_scc1 L_disp24_26
s_branch L_ld22
L_disp24_26:
s_cmp_ge_u32 s57, 26
s_cbranch_scc1 L_ld26
s_branch L_ld24
L_disp28_34:
s_cmp_ge_u32 s57, 32
s_cbranch_scc1 L_disp32_34
s_cmp_ge_u32 s57, 30
s_cbranch_scc1 L_ld30
s_branch L_ld28
L_disp32_34:
s_cmp_ge_u32 s57, 34
s_cbranch_scc1 L_ld34
s_branch L_ld32
.p2align 6
L_ld8:
v_readlane_b32 s52, v2, s48
v_readlane_b32 s18, v4, s48
v_readlane_b32 s53, v3, s48
v_readlane_b32 s22, v5, s48
s_mov_b32 m0, s49
s_sub_u32 s48, s48, 1
s_add_u32 s49, s49, 8192
s_sub_i32 s51, s42, 0
s_add_u32 s42, s42, 1
s_waitcnt vmcnt(7)
buffer_load_dwordx4 v8, s[16:19], s52 offen offset:0 nt lds
s_waitcnt vmcnt(7)
buffer_load_dwordx4 v9, s[16:19], s52 offen offset:1024 nt lds
s_waitcnt vmcnt(7)
buffer_load_dwordx4 v10, s[16:19], s52 offen offset:2048 nt lds
s_waitcnt vmcnt(7)
buffer_load_dwordx4 v11, s[16:19], s52 offen offset:3072 nt lds
s_add_u32 m0, m0, 4096
s_waitcnt vmcnt(7)
buffer_load_dwordx4 v8, s[20:23], s53 offen offset:0 nt lds
s_waitcnt vmcnt(7)
buffer_load_dwordx4 v9, s[20:23], s53 offen offset:1024 nt lds
ds_read_b32 v33, v32
s_waitcnt vmcnt(7)
buffer_load_dwordx4 v10, s[20:23], s53 offen offset:2048 nt lds
s_cmp_lt_i32 s51, s46
s_waitcnt vmcnt(7)
s_cbranch_scc1 L_ld8_np
s_barrier
s_add_u32 s43, s43, s44
s_add_u32 s51, s51, 3
s_max_i32 s46, s43, s51
s_cmp_eq_u32 s43, s45
s_cselect_b32 s44, s41, 4
L_ld8_np:
buffer_load_dwordx4 v11, s[20:23], s53 offen offset:3072 nt lds
s_sub_u32 s50, s50, 1
s_cmp_lg_u32 s50, 0
s_cbranch_scc1 L_ld8
s_branch L_next
.p2align 6
L_ld10:
v_readlane_b32 s52, v2, s48
v_readlane_b32 s18, v4, s48
v_readlane_b32 s53, v3, s48
v_readlane_b32 s22, v5, s48
s_mov_b32 m0, s49
s_sub_u32 s48, s48, 1
s_add_u32 s49, s49, 8192
s_sub_i32 s51, s42, 1
s_add_u32 s42, s42, 1
s_waitcnt vmcnt(9)
buffer_load_dwordx4 v8, s[16:19], s52 offen offset:0 nt lds
s_cmp_lt_i32 s51, s46
s_waitcnt vmcnt(9)
s_cbranch_scc1 L_ld10_np
s_barrier
s_add_u32 s43, s43, s44
s_add_u32 s51, s51, 3
s_max_i32 s46, s43, s51
s_cmp_eq_u32 s43, s45
s_cselect_b32 s44, s41, 4
L_ld10_np:
buffer_load_dwordx4 v9, s[16:19], s52 offen offset:1024 nt lds
s_waitcnt vmcnt(9)
buffer_load_dwordx4 v10, s[16:19], s52 offen offset:2048 nt lds
s_waitcnt vmcnt(9)
buffer_load_dwordx4 v11, s[16:19], s52 offen offset:3072 nt lds
s_add_u32 m0, m0, 4096
s_waitcnt vmcnt(9)
buffer_load_dwordx4 v8, s[20:23], s53 offen offset:0 nt lds
s_waitcnt vmcnt(9)
buffer_load_dwordx4 v9, s[20:23], s53 offen offset:1024 nt lds
ds_read_b32 v33, v32
s_waitcnt vmcnt(9)
buffer_load_dwordx4 v10, s[20:23], s53 offen offset:2048 nt lds
s_waitcnt vmcnt(9)
buffer_load_dwordx4 v11, s[20:23], s53 offen offset:3072 nt lds
s_sub_u32 s50, s50, 1
s_cmp_lg_u32 s50, 0
s_cbranch_scc1 L_ld10
s_branch L_next
.p2align 6
L_ld12:
v_readlane_b32 s52, v2, s48
v_readlane_b32 s18, v4, s48
v_readlane_b32 s53, v3, s48
v_readlane_b32 s22, v5, s48
s_mov_b32 m0, s49
s_sub_u32 s48, s48, 1
s_add_u32 s49, s49, 8192
s_sub_i32 s51, s42, 1
s_add_u32 s42, s42, 1
s_waitcnt vmcnt(11)
buffer_load_dwordx4 v8, s[16:19], s52 offen offset:0 nt lds
s_waitcnt vmcnt(11)
buffer_load_dwordx4 v9, s[16:19], s52 offen offset:1024 nt lds
s_waitcnt vmcnt(11)
buffer_load_dwordx4 v10, s[16:19], s52 offen offset:2048 nt lds
s_cmp_lt_i32 s51, s46
s_waitcnt vmcnt(11)
s_cbranch_scc1 L_ld12_np
s_barrier
s_add_u32 s43, s43, s44
s_add_u32 s51, s51, 3
s_max_i32 s46, s43, s51
s_cmp_eq_u32 s43, s45
s_cselect_b32 s44, s41, 4
L_ld12_np:
buffer_load_dwordx4 v11, s[16:19], s52 offen offset:3072 nt lds
s_add_u32 m0, m0, 4096
s_waitcnt vmcnt(11)
buffer_load_dwordx4 v8, s[20:23], s53 offen offset:0 nt lds
s_waitcnt vmcnt(11)
buffer_load_dwordx4 v9, s[20:23], s53 offen offset:1024 nt lds
ds_read_b32 v33, v32
s_waitcnt vmcnt(11)
buffer_load_dwordx4 v10, s[20:23], s53 offen offset:2048 nt lds
s_waitcnt vmcnt(11)
buffer_load_dwordx4 v11, s[20:23], s53 offen offset:3072 nt lds
s_sub_u32 s50, s50, 1
s_cmp_lg_u32 s50, 0
s_cbranch_scc1 L_ld12
s_branch L_next
.p2align 6
L_ld14:
v_readlane_b32 s52, v2, s48
v_readlane_b32 s18, v4, s48
v_readlane_b32 s53, v3, s48
v_readlane_b32 s22, v5, s48
s_mov_b32 m0, s49
s_sub_u32 s48, s48, 1
s_add_u32 s49, s49, 8192
s_sub_i32 s51, s42, 1
s_add_u32 s42, s42, 1
s_waitcnt vmcnt(13)
buffer_load_dwordx4 v8, s[16:19], s52 offen offset:0 nt lds
s_waitcnt vmcnt(13)
buffer_load_dwordx4 v9, s[16:19], s52 offen offset:1024 nt lds
s_waitcnt vmcnt(13)
buffer_load_dwordx4 v10, s[16:19], s52 offen offset:2048 nt lds
s_waitcnt vmcnt(13)
buffer_load_dwordx4 v11, s[16:19], s52 offen offset:3072 nt lds
s_add_u32 m0, m0, 4096
s_waitcnt vmcnt(13)
buffer_load_dwordx4 v8, s[20:23], s53 offen offset:0 nt lds
s_cmp_lt_i32 s51, s46
s_waitcnt vmcnt(13)
s_cbranch_scc1 L_ld14_np
s_barrier
s_add_u32 s43, s43, s44
s_add_u32 s51, s51, 3
s_max_i32 s46, s43, s51
s_cmp_eq_u32 s43, s45
s_cselect_b32 s44, s41, 4
L_ld14_np:
buffer_load_dwordx4 v9, s[20:23], s53 offen offset:1024 nt lds
ds_read_b32 v33, v32
s_waitcnt vmcnt(13)
buffer_load_dwordx4 v10, s[20:23], s53 offen offset:2048 nt lds
s_waitcnt vmcnt(13)
buffer_load_dwordx4 v11, s[20:23], s53 offen offset:3072 nt lds
s_sub_u32 s50, s50, 1
s_cmp_lg_u32 s50, 0
s_cbranch_scc1 L_ld14
s_branch L_next
.p2align 6
L_ld16:
v_readlane_b32 s52, v2, s48
v_readlane_b32 s18, v4, s48
v_readlane_b32 s53, v3, s48
v_readlane_b32 s22, v5, s48
s_mov_b32 m0, s49
s_sub_u32 s48, s48, 1
s_add_u32 s49, s49, 8192
s_sub_i32 s51, s42, 1
s_add_u32 s42, s42, 1
s_waitcnt vmcnt(15)
buffer_load_dwordx4 v8, s[16:19], s52 offen offset:0 nt lds
s_waitcnt vmcnt(15)
buffer_load_dwordx4 v9, s[16:19], s52 offen offset:1024 nt lds
s_waitcnt vmcnt(15)
buffer_load_dwordx4 v10, s[16:19], s52 offen offset:2048 nt lds
s_waitcnt vmcnt(15)
buffer_load_dwordx4 v11, s[16:19], s52 offen offset:3072 nt lds
s_add_u32 m0, m0, 4096
s_waitcnt vmcnt(15)
buffer_load_dwordx4 v8, s[20:23], s53 offen offset:0 nt lds
s_waitcnt vmcnt(15)
buffer_load_dwordx4 v9, s[20:23], s53 offen offset:1024 nt lds
ds_read_b32 v33, v32
s_waitcnt vmcnt(15)
buffer_load_dwordx4 v10, s[20:23], s53 offen offset:2048 nt lds
s_cmp_lt_i32 s51, s46
s_waitcnt vmcnt(15)
s_cbranch_scc1 L_ld16_np
s_barrier
s_add_u32 s43, s43, s44
s_add_u32 s51, s51, 3
s_max_i32 s46, s43, s51
s_cmp_eq_u32 s43, s45
s_cselect_b32 s44, s41, 4
L_ld16_np:
buffer_load_dwordx4 v11, s[20:23], s53 offen offset:3072 nt lds
s_sub_u32 s50, s50, 1
s_cmp_lg_u32 s50, 0
s_cbranch_scc1 L_ld16
s_branch L_next
.p2align 6
L_ld18:
v_readlane_b32 s52, v2, s48
v_readlane_b32 s18, v4, s48
v_readlane_b32 s53, v3, s48
v_readlane_b32 s22, v5, s48
s_mov_b32 m0, s49
s_sub_u32 s48, s48, 1
s_add_u32 s49, s49, 8192
s_sub_i32 s51, s42, 2
s_add_u32 s42, s42, 1
s_waitcnt vmcnt(17)
buffer_load_dwordx4 v8, s[16:19], s52 offen offset:0 nt lds
s_cmp_lt_i32 s51, s46
s_waitcnt vmcnt(17)
s_cbranch_scc1 L_ld18_np
s_barrier
s_add_u32 s43, s43, s44
s_add_u32 s51, s51, 3
s_max_i32 s46, s43, s51
s_cmp_eq_u32 s43, s45
s_cselect_b32 s44, s41, 4
L_ld18_np:
buffer_load_dwordx4 v9, s[16:19], s52 offen offset:1024 nt lds
s_waitcnt vmcnt(17)
buffer_load_dwordx4 v10, s[16:19], s52 offen offset:2048 nt lds
s_waitcnt vmcnt(17)
buffer_load_dwordx4 v11, s[16:19], s52 offen offset:3072 nt lds
s_add_u32 m0, m0, 4096
s_waitcnt vmcnt(17)
buffer_load_dwordx4 v8, s[20:23], s53 offen offset:0 nt lds
s_waitcnt vmcnt(17)
buffer_load_dwordx4 v9, s[20:23], s53 offen offset:1024 nt lds
ds_read_b32 v33, v32
s_waitcnt vmcnt(17)
buffer_load_dwordx4 v10, s[20:23], s53 offen offset:2048 nt lds
s_waitcnt vmcnt(17)
buffer_load_dwordx4 v11, s[20:23], s53 offen offset:3072 nt lds
s_sub_u32 s50, s50, 1
s_cmp_lg_u32 s50, 0
s_cbranch_scc1 L_ld18
s_branch L_next
.p2align 6
L_ld20:
v_readlane_b32 s52, v2, s48
v_readlane_b32 s18, v4, s48
v_readlane_b32 s53, v3, s48
v_readlane_b32 s22, v5, s48
s_mov_b32 m0, s49
s_sub_u32 s48, s48, 1
s_add_u32 s49, s49, 8192
s_sub_i32 s51, s42, 2
s_add_u32 s42, s42, 1
s_waitcnt vmcnt(19)
buffer_load_dwordx4 v8, s[16:19], s52 offen offset:0 nt lds
s_waitcnt vmcnt(19)
buffer_load_dwordx4 v9, s[16:19], s52 offen offset:1024 nt lds
s_waitcnt vmcnt(19)
buffer_load_dwordx4 v10, s[16:19], s52 offen offset:2048 nt lds
s_cmp_lt_i32 s51, s46
s_waitcnt vmcnt(19)
s_cbranch_scc1 L_ld20_np
s_barrier
s_add_u32 s43, s43, s44
s_add_u32 s51, s51, 3
s_max_i32 s46, s43, s51
s_cmp_eq_u32 s43, s45
s_cselect_b32 s44, s41, 4
L_ld20_np:
buffer_load_dwordx4 v11, s[16:19], s52 offen offset:3072 nt lds
s_add_u32 m0, m0, 4096
s_waitcnt vmcnt(19)
buffer_load_dwordx4 v8, s[20:23], s53 offen offset:0 nt lds
s_waitcnt vmcnt(19)
buffer_load_dwordx4 v9, s[20:23], s53 offen offset:1024 nt lds
ds_read_b32 v33, v32
s_waitcnt vmcnt(19)
buffer_load_dwordx4 v10, s[20:23], s53 offen offset:2048 nt lds
s_waitcnt vmcnt(19)
buffer_load_dwordx4 v11, s[20:23], s53 offen offset:3072 nt lds
s_sub_u32 s50, s50, 1
s_cmp_lg_u32 s50, 0
s_cbranch_scc1 L_ld20
s_branch L_next
.p2align 6
L_ld22:
v_readlane_b32 s52, v2, s48
v_readlane_b32 s18, v4, s48
v_readlane_b32 s53, v3, s48
v_readlane_b32 s22, v5, s48
s_mov_b32 m0, s49
s_sub_u32 s48, s48, 1
s_add_u32 s49, s49, 8192
s_sub_i32 s51, s42, 2
s_add_u32 s42, s42, 1
s_waitcnt vmcnt(21)
buffer_load_dwordx4 v8, s[16:19], s52 offen offset:0 nt lds
s_waitcnt vmcnt(21)
buffer_load_dwordx4 v9, s[16:19], s52 offen offset:1024 nt lds
s_waitcnt vmcnt(21)
buffer_load_dwordx4 v10, s[16:19], s52 offen offset:2048 nt lds
s_waitcnt vmcnt(21)
buffer_load_dwordx4 v11, s[16:19], s52 offen offset:3072 nt lds
s_add_u32 m0, m0, 4096
s_waitcnt vmcnt(21)
buffer_load_dwordx4 v8, s[20:23], s53 offen offset:0 nt lds
s_cmp_lt_i32 s51, s46
s_waitcnt vmcnt(21)
s_cbranch_scc1 L_ld22_np
s_barrier
s_add_u32 s43, s43, s44
s_add_u32 s51, s51, 3
s_max_i32 s46, s43, s51
s_cmp_eq_u32 s43, s45
s_cselect_b32 s44, s41, 4
L_ld22_np:
buffer_load_dwordx4 v9, s[20:23], s53 offen offset:1024 nt lds
ds_read_b32 v33, v32
s_waitcnt vmcnt(21)
buffer_load_dwordx4 v10, s[20:23], s53 offen offset:2048 nt lds
s_waitcnt vmcnt(21)
buffer_load_dwordx4 v11, s[20:23], s53 offen offset:3072 nt lds
s_sub_u32 s50, s50, 1
s_cmp_lg_u32 s50, 0
s_cbranch_scc1 L_ld22
s_branch L_next
.p2align 6
L_ld24:
v_readlane_b32 s52, v2, s48
v_readlane_b32 s18, v4, s48
v_readlane_b32 s53, v3, s48
v_readlane_b32 s22, v5, s48
s_mov_b32 m0, s49
s_sub_u32 s48, s48, 1
s_add_u32 s49, s49, 8192
s_sub_i32 s51, s42, 2
s_add_u32 s42, s42, 1
s_waitcnt vmcnt(23)
buffer_load_dwordx4 v8, s[16:19], s52 offen offset:0 nt lds
s_waitcnt vmcnt(23)
buffer_load_dwordx4 v9, s[16:19], s52 offen offset:1024 nt lds
s_waitcnt vmcnt(23)
buffer_load_dwordx4 v10, s[16:19], s52 offen offset:2048 nt lds
s_waitcnt vmcnt(23)
buffer_load_dwordx4 v11, s[16:19], s52 offen offset:3072 nt lds
s_add_u32 m0, m0, 4096
s_waitcnt vmcnt(23)
buffer_load_dwordx4 v8, s[20:23], s53 offen offset:0 nt lds
s_waitcnt vmcnt(23)
buffer_load_dwordx4 v9, s[20:23], s53 offen offset:1024 nt lds
ds_read_b32 v33, v32
s_waitcnt vmcnt(23)
buffer_load_dwordx4 v10, s[20:23], s53 offen offset:2048 nt lds
s_cmp_lt_i32 s51, s46
s_waitcnt vmcnt(23)
s_cbranch_scc1 L_ld24_np
s_barrier
s_add_u32 s43, s43, s44
s_add_u32 s51, s51, 3
s_max_i32 s46, s43, s51
s_cmp_eq_u32 s43, s45
s_cselect_b32 s44, s41, 4
L_ld24_np:
buffer_load_dwordx4 v11, s[20:23], s53 offen offset:3072 nt lds
s_sub_u32 s50, s50, 1
s_cmp_lg_u32 s50, 0
s_cbranch_scc1 L_ld24
s_branch L_next
.p2align 6
L_ld26:
v_readlane_b32 s52, v2, s48
v_readlane_b32 s18, v4, s48
v_readlane_b32 s53, v3, s48
v_readlane_b32 s22, v5, s48
s_mov_b32 m0, s49
s_sub_u32 s48, s48, 1
s_add_u32 s49, s49, 8192
s_sub_i32 s51, s42, 3
s_add_u32 s42, s42, 1
s_waitcnt vmcnt(25)
buffer_load_dwordx4 v8, s[16:19], s52 offen offset:0 nt lds
s_cmp_lt_i32 s51, s46
s_waitcnt vmcnt(25)
s_cbranch_scc1 L_ld26_np
s_barrier
s_add_u32 s43, s43, s44
s_add_u32 s51, s51, 3
s_max_i32 s46, s43, s51
s_cmp_eq_u32 s43, s45
s_cselect_b32 s44, s41, 4
L_ld26_np:
buffer_load_dwordx4 v9, s[16:19], s52 offen offset:1024 nt lds
s_waitcnt vmcnt(25)
buffer_load_dwordx4 v10, s[16:19], s52 offen offset:2048 nt lds
s_waitcnt vmcnt(25)
buffer_load_dwordx4 v11, s[16:19], s52 offen offset:3072 nt lds
s_add_u32 m0, m0, 4096
s_waitcnt vmcnt(25)
buffer_load_dwordx4 v8, s[20:23], s53 offen offset:0 nt lds
s_waitcnt vmcnt(25)
buffer_load_dwordx4 v9, s[20:23], s53 offen offset:1024 nt lds
ds_read_b32 v33, v32
s_waitcnt vmcnt(25)
buffer_load_dwordx4 v10, s[20:23], s53 offen offset:2048 nt lds
s_waitcnt vmcnt(25)
buffer_load_dwordx4 v11, s[20:23], s53 offen offset:3072 nt lds
s_sub_u32 s50, s50, 1
s_cmp_lg_u32 s50, 0
s_cbranch_scc1 L_ld26
s_branch L_next
.p2align 6
L_ld28:
v_readlane_b32 s52, v2, s48
v_readlane_b32 s18, v4, s48
v_readlane_b32 s53, v3, s48
v_readlane_b32 s22, v5, s48
s_mov_b32 m0, s49
s_sub_u32 s48, s48, 1
s_add_u32 s49, s49, 8192
s_sub_i32 s51, s42, 3
s_add_u32 s42, s42, 1
s_waitcnt vmcnt(27)
buffer_load_dwordx4 v8, s[16:19], s52 offen offset:0 nt lds
s_waitcnt vmcnt(27)
buffer_load_dwordx4 v9, s[16:19], s52 offen offset:1024 nt lds
s_waitcnt vmcnt(27)
buffer_load_dwordx4 v10, s[16:19], s52 offen offset:2048 nt lds
s_cmp_lt_i32 s51, s46
s_waitcnt vmcnt(27)
s_cbranch_scc1 L_ld28_np
s_barrier
s_add_u32 s43, s43, s44
s_add_u32 s51, s51, 3
s_max_i32 s46, s43, s51
s_cmp_eq_u32 s43, s45
s_cselect_b32 s44, s41, 4
L_ld28_np:
buffer_load_dwordx4 v11, s[16:19], s52 offen offset:3072 nt lds
s_add_u32 m0, m0, 4096
s_waitcnt vmcnt(27)
buffer_load_dwordx4 v8, s[20:23], s53 offen offset:0 nt lds
s_waitcnt vmcnt(27)
buffer_load_dwordx4 v9, s[20:23], s53 offen offset:1024 nt lds
ds_read_b32 v33, v32
s_waitcnt vmcnt(27)
buffer_load_dwordx4 v10, s[20:23], s53 offen offset:2048 nt lds
s_waitcnt vmcnt(27)
buffer_load_dwordx4 v11, s[20:23], s53 offen offset:3072 nt lds
s_sub_u32 s50, s50, 1
s_cmp_lg_u32 s50, 0
s_cbranch_scc1 L_ld28
s_branch L_next
.p2align 6
L_ld30:
v_readlane_b32 s52, v2, s48
v_readlane_b32 s18, v4, s48
v_readlane_b32 s53, v3, s48
v_readlane_b32 s22, v5, s48
s_mov_b32 m0, s49
s_sub_u32 s48, s48, 1
s_add_u32 s49, s49, 8192
s_sub_i32 s51, s42, 3
s_add_u32 s42, s42, 1
s_waitcnt vmcnt(29)
buffer_load_dwordx4 v8, s[16:19], s52 offen offset:0 nt lds
s_waitcnt vmcnt(29)
buffer_load_dwordx4 v9, s[16:19], s52 offen offset:1024 nt lds
s_waitcnt vmcnt(29)
buffer_load_dwordx4 v10, s[16:19], s52 offen offset:2048 nt lds
s_waitcnt vmcnt(29)
buffer_load_dwordx4 v11, s[16:19], s52 offen offset:3072 nt lds
s_add_u32 m0, m0, 4096
s_waitcnt vmcnt(29)
buffer_load_dwordx4 v8, s[20:23], s53 offen offset:0 nt lds
s_cmp_lt_i32 s51, s46
s_waitcnt vmcnt(29)
s_cbranch_scc1 L_ld30_np
s_barrier
s_add_u32 s43, s43, s44
s_add_u32 s51, s51, 3
s_max_i32 s46, s43, s51
s_cmp_eq_u32 s43, s45
s_cselect_b32 s44, s41, 4
L_ld30_np:
buffer_load_dwordx4 v9, s[20:23], s53 offen offset:1024 nt lds
ds_read_b32 v33, v32
s_waitcnt vmcnt(29)
buffer_load_dwordx4 v10, s[20:23], s53 offen offset:2048 nt lds
s_waitcnt vmcnt(29)
buffer_load_dwordx4 v11, s[20:23], s53 offen offset:3072 nt lds
s_sub_u32 s50, s50, 1
s_cmp_lg_u32 s50, 0
s_cbranch_scc1 L_ld30
s_branch L_next
.p2align 6
L_ld34:
v_readlane_b32 s52, v2, s48
v_readlane_b32 s18, v4, s48
v_readlane_b32 s53, v3, s48
v_readlane_b32 s22, v5, s48
s_mov_b32 m0, s49
s_sub_u32 s48, s48, 1
s_add_u32 s49, s49, 8192
s_sub_i32 s51, s42, 4
s_add_u32 s42, s42, 1
s_waitcnt vmcnt(33)
buffer_load_dwordx4 v8, s[16:19], s52 offen offset:0 nt lds
s_cmp_lt_i32 s51, s46
s_waitcnt vmcnt(33)
s_cbranch_scc1 L_ld34_np
s_barrier
s_add_u32 s43, s43, s44
s_add_u32 s51, s51, 3
s_max_i32 s46, s43, s51
s_cmp_eq_u32 s43, s45
s_cselect_b32 s44, s41, 4
L_ld34_np:
buffer_load_dwordx4 v9, s[16:19], s52 offen offset:1024 nt lds
s_waitcnt vmcnt(33)
buffer_load_dwordx4 v10, s[16:19], s52 offen offset:2048 nt lds
s_waitcnt vmcnt(33)
buffer_load_dwordx4 v11, s[16:19], s52 offen offset:3072 nt lds
s_add_u32 m0, m0, 4096
s_waitcnt vmcnt(33)
buffer_load_dwordx4 v8, s[20:23], s53 offen offset:0 nt lds
s_waitcnt vmcnt(33)
buffer_load_dwordx4 v9, s[20:23], s53 offen offset:1024 nt lds
ds_read_b32 v33, v32
s_waitcnt vmcnt(33)
buffer_load_dwordx4 v10, s[20:23], s53 offen offset:2048 nt lds
s_waitcnt vmcnt(33)
buffer_load_dwordx4 v11, s[20:23], s53 offen offset:3072 nt lds
s_sub_u32 s50, s50, 1
s_cmp_lg_u32 s50, 0
s_cbranch_scc1 L_ld34
s_branch L_next
L_drain:
L_drain6:
s_sub_i32 s51, s47, s43
s_cmp_lt_i32 s51, 6
s_cbranch_scc1 L_drain6_n
s_waitcnt vmcnt(48)
s_barrier
s_add_u32 s43, s43, s44
s_cmp_eq_u32 s43, s45
s_cselect_b32 s44, s41, 4
s_branch L_drain6
L_drain6_n:
L_drain5:
s_sub_i32 s51, s47, s43
s_cmp_lt_i32 s51, 5
s_cbranch_scc1 L_drain5_n
s_waitcnt vmcnt(40)
s_barrier
s_add_u32 s43, s43, s44
s_cmp_eq_u32 s43, s45
s_cselect_b32 s44, s41, 4
s_branch L_drain5
L_drain5_n:
L_drain4:
s_sub_i32 s51, s47, s43
s_cmp_lt_i32 s51, 4
s_cbranch_scc1 L_drain4_n
s_waitcnt vmcnt(32)
s_barrier
s_add_u32 s43, s43, s44
s_cmp_eq_u32 s43, s45
s_cselect_b32 s44, s41, 4
s_branch L_drain4
L_drain4_n:
L_drain3:
s_sub_i32 s51, s47, s43
s_cmp_lt_i32 s51, 3
s_cbranch_scc1 L_drain3_n
s_waitcnt vmcnt(24)
s_barrier
s_add_u32 s43, s43, s44
s_cmp_eq_u32 s43, s45
s_cselect_b32 s44, s41, 4
s_branch L_drain3
L_drain3_n:
L_drain2:
s_sub_i32 s51, s47, s43
s_cmp_lt_i32 s51, 2
s_cbranch_scc1 L_drain2_n
s_waitcnt vmcnt(16)
s_barrier
s_add_u32 s43, s43, s44
s_cmp_eq_u32 s43, s45
s_cselect_b32 s44, s41, 4
s_branch L_drain2
L_drain2_n:
L_drain1:
s_sub_i32 s51, s47, s43
s_cmp_lt_i32 s51, 1
s_cbranch_scc1 L_drain1_n
s_waitcnt vmcnt(8)
s_barrier
s_add_u32 s43, s43, s44
s_cmp_eq_u32 s43, s45
s_cselect_b32 s44, s41, 4
s_branch L_drain1
L_drain1_n:
s_cmp_gt_u32 s47, 8
s_cbranch_scc1 L_last3
s_waitcnt vmcnt(0)
L_last3:
s_waitcnt vmcnt(8)
s_barrier
s_waitcnt vmcnt(0)
s_barrier
s_endpgm
L_notloader:
s_mov_b32 s66, 0x2875d74e
s_mov_b32 s67, 0x28b2c74e
s_lshl_b32 s33, s32, 1
s_lshr_b64 s[38:39], s[66:67], s33
s_and_b32 s38, s38, 3
s_and_b32 s33, s32, 4
s_add_u32 s33, s33, s38
s_add_u32 s33, s33, s2
s_and_b32 s33, s33, 7
s_cmp_lt_u32 s34, 5
s_cbranch_scc1 L_consumer
s_and_b32 s35, s33, 3
v_and_b32 v6, 31, v0
v_lshrrev_b32 v9, 5, v0
v_lshlrev_b32 v9, 4, v9
v_xor_b32 v9, v9, v6
v_lshlrev_b32 v12, 2, v6
v_lshlrev_b32 v13, 2, v9
v_lshlrev_b32 v15, 1, v6
v_lshlrev_b32 v16, 1, v9
v_lshrrev_b64 v[20:21], v15, s[66:67]
v_lshrrev_b64 v[22:23], v16, s[66:67]
v_add_u32 v15, s2, v20
v_add_u32 v16, s2, v22
v_and_b32 v15, 3, v15
v_and_b32 v16, 3, v16
v_cmp_eq_u32 vcc, 1, v15
v_cmp_eq_u32 s[40:41], 1, v16
v_mov_b32 v15, 0x100000
s_nop 0
v_cndmask_b32 v16, 0, v15, s[40:41]
v_cndmask_b32 v15, 0, v15, vcc
v_add_u32 v6, v6, v15
v_add_u32 v9, v9, v16
s_waitcnt lgkmcnt(0)
s_mov_b64 s[30:31], s[16:17]
global_load_dword v7, v12, s[12:13]
global_load_dword v14, v13, s[12:13]
s_mov_b32 s16, s6
s_mov_b32 s17, s7
s_mov_b32 s18, 134348800
s_mov_b32 s19, 0x20000
v_lshrrev_b32 v8, 2, v0
v_lshlrev_b32 v8, 11, v8
v_and_b32 v10, 3, v0
v_lshl_add_u32 v8, v10, 6, v8
v_mov_b32 v19, 2048
v_mov_b32 v10, 0
s_getreg_b32 s48, hwreg(HW_REG_XCC_ID, 0, 3)
v_mov_b32 v32, 158720
s_mov_b32 s62, 0x7091708f
s_mov_b32 s63, 0x6d907293
s_lshl_b32 s49, s48, 3
s_lshr_b64 s[62:63], s[62:63], s49
s_and_b32 s49, s62, 255
s_add_u32 s49, s49, 896
s_lshl_b32 s48, s48, 5
s_add_u32 s47, s48, s32
v_mov_b32 v17, s47
v_and_b32 v28, 7, v0
v_lshlrev_b32 v28, 2, v28
v_add_u32 v28, s48, v28
s_waitcnt vmcnt(0)
v_cmp_lt_i32 vcc, 0, v7
v_cmp_lt_i32 s[40:41], 0, v14
v_min_i32 v7, v7, v19
v_min_i32 v14, v14, v19
v_cndmask_b32 v7, v19, v7, vcc
v_cndmask_b32 v14, v19, v14, s[40:41]
v_lshl_add_u32 v11, v7, 5, v6
v_lshl_add_u32 v14, v14, 5, v9
v_add_u32_dpp v15, v7, v7 row_shr:1 row_mask:0xf bank_mask:0xf bound_ctrl:0
v_sub_u32 v12, v14, v11
v_sub_u32_dpp v13, v14, v11 row_ror:1 row_mask:0xf bank_mask:0xf
v_alignbit_b32 v10, v10, v12, 31
v_sub_u32_dpp v12, v14, v11 row_ror:2 row_mask:0xf bank_mask:0xf
v_alignbit_b32 v10, v10, v13, 31
v_add_u32_dpp v15, v15, v15 row_shr:2 row_mask:0xf bank_mask:0xf bound_ctrl:0
v_sub_u32_dpp v13, v14, v11 row_ror:3 row_mask:0xf bank_mask:0xf
v_alignbit_b32 v10, v10, v12, 31
v_sub_u32_dpp v12, v14, v11 row_ror:4 row_mask:0xf bank_mask:0xf
v_alignbit_b32 v10, v10, v13, 31
v_add_u32_dpp v15, v15, v15 row_shr:4 row_mask:0xf bank_mask:0xf bound_ctrl:0
v_sub_u32_dpp v13, v14, v11 row_ror:5 row_mask:0xf bank_mask:0xf
v_alignbit_b32 v10, v10, v12, 31
v_sub_u32_dpp v12, v14, v11 row_ror:6 row_mask:0xf bank_mask:0xf
v_alignbit_b32 v10, v10, v13, 31
v_add_u32_dpp v15, v15, v15 row_shr:8 row_mask:0xf bank_mask:0xf bound_ctrl:0
v_sub_u32_dpp v13, v14, v11 row_ror:7 row_mask:0xf bank_mask:0xf
v_alignbit_b32 v10, v10, v12, 31
v_sub_u32_dpp v12, v14, v11 row_ror:8 row_mask:0xf bank_mask:0xf
v_alignbit_b32 v10, v10, v13, 31
v_add_u32_dpp v15, v15, v15 row_bcast:15 row_mask:0xa bank_mask:0xf
v_sub_u32_dpp v13, v14, v11 row_ror:9 row_mask:0xf bank_mask:0xf
v_alignbit_b32 v10, v10, v12, 31
v_sub_u32_dpp v12, v14, v11 row_ror:10 row_mask:0xf bank_mask:0xf
v_alignbit_b32 v10, v10, v13, 31
v_sub_u32_dpp v13, v14, v11 row_ror:11 row_mask:0xf bank_mask:0xf
v_alignbit_b32 v10, v10, v12, 31
v_sub_u32_dpp v12, v14, v11 row_ror:12 row_mask:0xf bank_mask:0xf
v_alignbit_b32 v10, v10, v13, 31
v_sub_u32_dpp v13, v14, v11 row_ror:13 row_mask:0xf bank_mask:0xf
v_alignbit_b32 v10, v10, v12, 31
v_sub_u32_dpp v12, v14, v11 row_ror:14 row_mask:0xf bank_mask:0xf
v_alignbit_b32 v10, v10, v13, 31
v_sub_u32_dpp v13, v14, v11 row_ror:15 row_mask:0xf bank_mask:0xf
v_alignbit_b32 v10, v10, v12, 31
v_alignbit_b32 v10, v10, v13, 31
v_bcnt_u32_b32 v10, v10, 0
v_readlane_b32 s40, v15, 31
v_mov_b32 v12, v10
v_readlane_b32 s38, v7, s32
s_nop 0
v_permlane32_swap_b32 v10, v12
v_add_u32 v10, v10, v12
v_cvt_f32_u32 v24, s40
v_readlane_b32 s41, v10, s32
v_mul_f32 v13, 0x3afd70a4, v24
v_cvt_f32_u32 v12, v7
v_rcp_f32 v24, v24
s_mov_b32 s60, 0x9010800
s_mov_b32 s61, 0x18191110
s_mov_b32 s62, 0x3120a02
s_mov_b32 s63, 0x140c040b
s_mov_b32 s64, 0x6150d05
s_mov_b32 s65, 0xf07160e
s_cmp_ge_u32 s41, 8
s_cselect_b64 s[60:61], s[62:63], s[60:61]
s_cmp_ge_u32 s41, 16
s_cselect_b64 s[60:61], s[64:65], s[60:61]
s_lshl_b32 s41, s41, 3
s_lshr_b64 s[60:61], s[60:61], s41
s_and_b32 s36, s60, 7
s_bfe_u32 s44, s60, 0x30003
s_lshl_b32 s60, s36, 2
s_lshr_b32 s64, 0x23332344, s60
s_and_b32 s64, s64, 15
s_sub_u32 s41, 31, s36
s_cmp_eq_u32 s35, 1
s_cselect_b32 s36, 100, s44
s_mul_i32 s65, s64, 1
v_cmp_eq_u32 vcc, s41, v10
v_mul_f32 v12, 0x3d800000, v12
v_sub_f32 v12, v12, v13
v_cvt_i32_f32 v12, v12
v_lshrrev_b32 v13, 5, v7
v_min_i32 v12, v12, v13
s_ff1_i32_b32 s41, vcc_lo
s_and_b32 s41, s41, 31
v_readlane_b32 s45, v12, s41
v_readlane_b32 s55, v12, s32
v_readlane_b32 s56, v7, s41
s_lshl_b32 s43, s41, 9
v_add_u32 v1, s43, v1
global_load_dwordx2 v[2:3], v1, s[10:11]
v_cvt_f32_u32 v25, s38
s_lshl_b32 s37, s41, 1
s_lshr_b64 s[62:63], s[66:67], s37
s_and_b32 s62, s62, 3
s_and_b32 s37, s41, 4
s_add_u32 s37, s37, s62
s_add_u32 s37, s37, s2
s_and_b32 s37, s37, 7
s_lshl_b32 s37, s37, 8
s_add_u32 s36, s36, 1
s_sub_i32 s45, s45, s36
s_add_u32 s38, s38, 31
s_lshr_b32 s38, s38, 5
s_add_u32 s42, s38, 3
s_lshr_b32 s58, s42, 2
s_lshl_b32 s42, s58, 1
s_mov_b32 s59, s45
v_mul_f32 v25, v25, v24
s_cmp_eq_u32 s33, 7
s_mov_b32 s60, 0x47600000
s_cselect_b32 s60, 0x48200000, s60
v_subrev_f32 v27, 0x3d0a3d71, v25
v_max_f32 v27, 0, v27
v_mov_b32 v26, 0xc3a66666
v_fma_f32 v26, v27, s60, v26
v_mul_f32 v25, 0x48300000, v25
v_add_f32 v26, v26, v25
v_cvt_f32_u32 v27, s49
v_mul_f32 v26, 0x3a800000, v26
v_mul_f32 v26, v27, v26
s_max_i32 s55, s55, 0
s_cmp_eq_u32 s35, 1
s_cselect_b32 s55, s55, 0
v_cvt_u32_f32 v30, v26
v_cvt_f32_u32 v12, s38
v_cvt_f32_u32 v16, s55
v_mov_b32 v18, 0xbecccccd
v_fma_f32 v12, v16, v18, v12
v_add_f32 v12, v12, v12
v_rcp_f32 v12, v12
s_mul_i32 s46, s42, 236
s_lshr_b32 s46, s46, 8
s_mul_i32 s50, s42, 218
s_lshr_b32 s50, s50, 8
v_mov_b32 v19, -1
s_mov_b32 s51, 0
s_sub_u32 s42, s42, 2
s_sub_u32 s56, s56, 1
s_lshr_b32 s56, s56, 5
s_and_b32 s57, s56, 3
s_min_u32 s57, s57, 2
s_sub_u32 s56, s56, s57
s_barrier
ds_write_b32 v32, v30
s_cmp_lt_i32 s45, 0
s_cbranch_scc1 L_pf_nosort
s_waitcnt vmcnt(0)
v_lshlrev_b32 v38, 2, v0
v_mov_b32 v39, 0
v_add_u32 v38, 159744, v38
v_lshrrev_b32 v34, 6, v2
ds_write_b32 v38, v39
v_lshrrev_b32 v35, 6, v3
v_min_u32 v34, 63, v34
v_min_u32 v35, 63, v35
v_cmp_gt_i32 vcc, s56, v0
v_lshlrev_b32 v34, 2, v34
v_lshlrev_b32 v35, 2, v35
v_cndmask_b32 v41, 0, 1, vcc
v_add_u32 v39, 159744, v34
v_add_u32 v40, 159744, v35
ds_add_rtn_u32 v36, v39, v41
ds_add_rtn_u32 v37, v40, v41
ds_read_b32 v39, v38
s_waitcnt lgkmcnt(0)
s_nop 0
v_add_u32_dpp v40, v39, v39 row_shr:1 row_mask:0xf bank_mask:0xf bound_ctrl:0
s_nop 1
v_add_u32_dpp v40, v40, v40 row_shr:2 row_mask:0xf bank_mask:0xf bound_ctrl:0
s_nop 1
v_add_u32_dpp v40, v40, v40 row_shr:4 row_mask:0xf bank_mask:0xf bound_ctrl:0
s_nop 1
v_add_u32_dpp v40, v40, v40 row_shr:8 row_mask:0xf bank_mask:0xf bound_ctrl:0
s_nop 1
v_add_u32_dpp v40, v40, v40 row_bcast:15 row_mask:0xa bank_mask:0xf
s_nop 1
v_add_u32_dpp v40, v40, v40 row_bcast:31 row_mask:0xc bank_mask:0xf
v_sub_u32 v40, v40, v39
ds_bpermute_b32 v34, v34, v40
ds_bpermute_b32 v35, v35, v40
v_lshlrev_b32 v38, 1, v0
v_add_u32 v39, 1, v38
s_waitcnt lgkmcnt(0)
v_add_u32 v34, v34, v36
v_add_u32 v35, v35, v37
v_cndmask_b32 v34, v38, v34, vcc
v_cndmask_b32 v35, v39, v35, vcc
v_lshlrev_b32 v34, 2, v34
v_lshlrev_b32 v35, 2, v35
v_add_u32 v34, 160000, v34
v_add_u32 v35, 160000, v35
ds_write_b32 v34, v2
ds_write_b32 v35, v3
v_lshlrev_b32 v1, 3, v0
v_add_u32 v1, 160000, v1
ds_read_b64 v[2:3], v1
L_pf_nosort:
s_barrier
s_waitcnt vmcnt(0) lgkmcnt(0)
v_lshlrev_b32 v2, 15, v2
v_lshlrev_b32 v3, 15, v3
v_add_u32 v2, s37, v2
v_add_u32 v3, s37, v3
s_lshl_b32 s47, s32, 22
s_lshl_b32 s49, s2, 8
s_add_u32 s47, s47, s49
v_and_b32 v13, 1, v0
v_lshlrev_b32 v13, 21, v13
v_add_u32 v13, s47, v13
global_load_dword v20, v13, s[8:9] nt
s_mov_b32 s61, 0
L_pf_loop:
s_cmp_le_i32 s42, 1
s_cbranch_scc1 L_pf_exit
s_cmp_lg_u32 s42, s58
s_cbranch_scc1 L_pf_same
s_mov_b32 s16, s8
s_mov_b32 s17, s9
s_mov_b32 s45, s59
L_pf_same:
s_cmp_eq_u32 s42, 2
s_cselect_b32 s45, -1, s45
s_max_i32 s47, s45, 0
v_readlane_b32 s52, v2, s47
v_readlane_b32 s53, v3, s47
s_cmp_ge_u32 s42, s58
s_cselect_b32 s47, s58, 0
s_cselect_b32 s49, 0.5, 0
s_sub_u32 s47, s42, s47
s_lshl_b32 s47, s47, 2
v_cvt_f32_u32 v15, s47
v_mov_b32 v31, v34
v_subrev_f32 v14, 0x40000000, v15
v_min_f32 v13, v14, v16
v_fma_f32 v14, v13, v18, v14
v_fma_f32 v14, v14, v12, s49
v_mov_b32 v13, 0x437f8000
v_mul_f32 v14, 0xc37f0000, v14
v_add_f32 v14, v14, v13
v_min_f32 v14, v14, v13
v_cvt_u32_f32 v14, v14
s_mov_b32 s54, 0
s_cmp_gt_u32 s42, s46
s_cbranch_scc1 L_pf_pull
s_mov_b64 exec, 1
global_store_byte v17, v14, s[30:31]
s_mov_b64 exec, -1
s_cmp_gt_u32 s42, s50
s_cbranch_scc1 L_pf_pull
s_mov_b32 s54, s51
s_mov_b32 s51, 1
s_bitcmp1_b32 s42, 0
s_cbranch_scc1 L_pf_odd
s_cmp_lg_u32 s42, 2
s_cbranch_scc1 L_pf_even
s_waitcnt vmcnt(1)
s_branch L_pf_got
L_pf_even:
global_load_dword v35, v28, s[30:31] nt
s_branch L_pf_pull
L_pf_odd:
global_load_dword v36, v28, s[30:31] nt
L_pf_pull:
s_cmp_lt_i32 s45, 0
s_cbranch_scc1 L_pf_nopull
buffer_load_dword v20, v8, s[16:19], s52 offen nt
buffer_load_dword v21, v8, s[16:19], s52 offen
s_cmp_lg_u32 s61, 0
s_cbranch_scc1 L_pf_got
s_waitcnt vmcnt(4)
s_branch L_pf_got
L_pf_nopull:
s_cmp_lg_u32 s61, 0
s_cbranch_scc1 L_pf_got
s_waitcnt vmcnt(2)
L_pf_got:
s_mov_b32 s61, 0
v_min_f32 v13, v15, v16
v_fma_f32 v15, v13, v18, v15
v_fma_f32 v34, v15, v12, s49
s_cmp_eq_u32 s54, 0
s_cbranch_scc1 L_pf_nofb
s_bitcmp1_b32 s42, 0
s_cselect_b64 vcc, -1, 0
s_waitcnt lgkmcnt(0)
v_cndmask_b32 v30, v36, v35, vcc
v_msad_u8 v33, v19, v30, 0
v_sad_u8 v30, v30, 0, 0
v_lshl_add_u32 v30, v33, 16, v30
s_nop 1
v_add_u32_dpp v30, v30, v30 row_ror:1 row_mask:0xf bank_mask:0xf
s_nop 1
v_add_u32_dpp v30, v30, v30 row_ror:2 row_mask:0xf bank_mask:0xf
s_nop 1
v_add_u32_dpp v30, v30, v30 row_ror:4 row_mask:0xf bank_mask:0xf
v_lshrrev_b32 v33, 16, v30
v_and_b32 v30, 0xffff, v30
v_add_u32 v30, v30, v33
v_cvt_f32_u32 v30, v30
v_cvt_f32_u32 v33, v33
v_rcp_f32 v30, v30
s_nop 0
v_mul_f32 v30, v30, v33
v_cmp_lt_f32 vcc, 0.5, v30
v_subrev_f32 v33, 0.5, v30
s_nop 0
v_cndmask_b32 v29, v30, v33, vcc
v_max_f32 v33, 0x3e19999a, v29
v_mul_f32 v29, 0xbecccccd, v29
v_add_f32 v29, 0x3f8f5c29, v29
v_rcp_f32 v33, v33
v_sub_f32 v30, v31, v30
v_mul_f32 v30, 0x3fa66666, v30
v_fma_f32 v30, v30, v33, 1.0
v_max_f32 v30, 0x3f4ccccd, v30
v_min_f32 v30, 0x3fa00000, v30
v_mul_f32 v30, v30, v26
v_mul_f32 v30, v30, v29
s_cmp_ge_i32 s45, s65
s_cselect_b32 s47, 0x3f8f5c29, 1.0
v_mul_f32 v30, s47, v30
v_cvt_u32_f32 v30, v30
ds_write_b32 v32, v30
L_pf_nofb:
s_cmp_lt_i32 s45, 0
s_cbranch_scc1 L_pf_nov
s_sub_i32 s45, s45, s64
s_waitcnt vmcnt(0)
s_mov_b32 s61, 1
buffer_load_dword v22, v8, s[16:19], s53 offen nt
buffer_load_dword v23, v8, s[16:19], s53 offen
L_pf_nov:
s_sub_u32 s42, s42, 1
s_barrier
s_branch L_pf_loop
L_pf_exit:
s_endpgm
L_consumer:
s_sub_u32 s34, s34, 1
v_and_b32 v1, 31, v0
v_lshrrev_b32 v2, 5, v0
s_lshl_b32 s35, s32, 16
s_lshl_b32 s36, s33, 13
s_add_u32 s35, s35, s36
s_lshl_b32 s36, s32, 2
s_waitcnt lgkmcnt(0)
s_load_dword s37, s[12:13], s36
s_lshl_b32 s46, s34, 13
v_and_b32 v8, 3, v0
v_bfe_u32 v9, v0, 2, 2
v_lshl_add_u32 v10, v8, 2, v9
v_xor_b32 v10, v10, v2
v_lshlrev_b32 v10, 4, v10
v_lshl_add_u32 v10, v1, 8, v10
v_add_u32 v16, s46, v10
v_add_u32 v48, 150528, v10
v_xor_b32 v49, 32, v48
v_xor_b32 v50, 64, v48
v_xor_b32 v51, 96, v48
v_xor_b32 v52, 128, v48
v_xor_b32 v53, 160, v48
v_xor_b32 v54, 192, v48
v_xor_b32 v55, 224, v48
v_xor_b32 v17, 32, v16
v_xor_b32 v18, 64, v16
v_xor_b32 v19, 96, v16
v_xor_b32 v20, 128, v16
v_xor_b32 v21, 160, v16
v_xor_b32 v22, 192, v16
v_xor_b32 v23, 224, v16
v_lshl_add_u32 v10, v2, 2, v9
v_lshlrev_b32 v10, 8, v10
v_xor_b32 v11, s34, v9
v_lshl_add_u32 v10, v11, 6, v10
v_bfe_u32 v11, v0, 4, 1
v_bfe_u32 v12, v0, 1, 1
v_lshl_add_u32 v11, v11, 1, v12
v_xor_b32 v11, v11, v2
v_lshl_add_u32 v10, v11, 4, v10
v_and_b32 v11, 1, v0
v_lshl_add_u32 v24, v11, 3, v10
v_xor_b32 v25, 32, v24
v_lshlrev_b32 v10, 4, v0
v_add_u32 v5, 131072, v10
s_lshl_b32 s47, s34, 11
v_add_u32 v4, s47, v5
v_lshlrev_b32 v11, 5, v1
v_add_u32 v7, 147456, v11
s_lshl_b32 s47, s34, 3
v_lshl_add_u32 v6, v2, 2, v7
v_add_u32 v6, s47, v6
v_lshlrev_b32 v8, 2, v1
v_add_u32 v8, 160512, v8
v_add_u32 v9, 128, v8
v_mov_b32 v40, 0
v_mov_b32 v41, 0
v_mov_b32 v42, 0
v_mov_b32 v43, 0
v_mov_b32 v28, 0xf149f2ca
v_mov_b32 v33, 0xf149f2ca
v_mov_b32 v29, 0
v_mov_b32 v15, 0xff800000
s_lshl_b32 s47, s34, 6
s_add_u32 s47, s47, s35
v_lshrrev_b32 v36, 2, v0
v_and_b32 v37, 3, v0
v_lshlrev_b32 v3, 8, v36
v_lshl_add_u32 v3, v37, 4, v3
v_add_u32 v3, s47, v3
s_lshl_b32 s47, s34, 11
s_add_u32 s47, s47, 150528
v_bfe_u32 v38, v0, 3, 2
v_xor_b32 v37, v37, v38
v_lshlrev_b32 v37, 4, v37
v_lshl_add_u32 v37, v36, 6, v37
v_add_u32 v13, s47, v37
v_bfe_u32 v38, v0, 1, 2
v_lshlrev_b32 v38, 4, v38
v_lshl_add_u32 v38, v1, 6, v38
v_lshl_add_u32 v38, v2, 3, v38
v_add_u32 v36, s47, v38
v_xor_b32 v37, 16, v36
v_xor_b32 v38, 32, v36
v_xor_b32 v12, 48, v36
s_waitcnt lgkmcnt(0)
s_mov_b32 s48, 0x3e0293ee
s_cmp_gt_i32 s37, 0
s_cselect_b32 s48, s48, 0
s_cselect_b32 s37, s37, 2048
s_min_i32 s37, s37, 2048
s_add_u32 s38, s37, 31
s_lshr_b32 s38, s38, 5
s_sub_u32 s40, s38, 1
s_and_b32 s41, s40, 3
s_add_u32 s41, s41, 1
s_add_u32 s42, s38, 3
s_lshr_b32 s42, s42, 2
s_lshl_b32 s40, s40, 5
s_sub_u32 s40, s37, s40
s_cmp_eq_u32 s34, 0
s_cselect_b32 s40, s40, 64
s_cmp_lt_u32 s34, s41
s_cselect_b32 s40, s40, 0
v_lshlrev_b32 v14, 2, v2
v_sub_u32 v14, s40, v14
s_cbranch_scc1 L_active
s_cmp_gt_u32 s42, 4
s_cbranch_scc1 L_active
s_max_u32 s47, s42, 2
s_and_b32 s47, s47, 3
s_lshl_b32 s47, s47, 15
s_add_u32 s47, s47, s46
v_add_u32 v11, s47, v10
ds_write_b128 v11, v[40:43] offset:0
ds_write_b128 v11, v[40:43] offset:1024
ds_write_b128 v11, v[40:43] offset:2048
ds_write_b128 v11, v[40:43] offset:3072
ds_write_b128 v11, v[40:43] offset:4096
ds_write_b128 v11, v[40:43] offset:5120
ds_write_b128 v11, v[40:43] offset:6144
ds_write_b128 v11, v[40:43] offset:7168
L_active:
s_mov_b32 s43, 0
s_mov_b32 s44, 0x8000
s_mov_b32 s49, 0
s_waitcnt vmcnt(0) lgkmcnt(0)
s_barrier
ds_read_b128 v[64:67], v48
ds_read_b128 v[68:71], v49
ds_read_b128 v[72:75], v50
ds_read_b128 v[76:79], v51
ds_read_b128 v[80:83], v52
ds_read_b128 v[84:87], v53
ds_read_b128 v[88:91], v54
ds_read_b128 v[92:95], v55
s_mov_b32 s50, 0
L_K:
ds_read_b128 v[40:43], v7
ds_read_b128 v[44:47], v7 offset:16
ds_read_b128 v[96:99], v16
ds_read_b128 v[100:103], v17
ds_read_b128 v[104:107], v18
ds_read_b128 v[108:111], v19
ds_read_b128 v[112:115], v20
ds_read_b128 v[116:119], v21
ds_read_b128 v[120:123], v22
ds_read_b128 v[124:127], v23
s_cmp_eq_u32 s43, 0
s_cbranch_scc1 L_X
v_xor_b32 v7, 0x400, v7
s_waitcnt lgkmcnt(8)
v_max3_f32 v30, v40, v41, v42
v_max3_f32 v31, v43, v44, v45
v_max3_f32 v30, v30, v46, v47
v_max3_f32 v28, v30, v31, v28
v_mul_f32 v32, s48, v28
v_sub_f32 v31, v33, v32
v_mov_b32 v33, v32
v_exp_f32 v34, v31
v_fma_f32 v48, v48, s48, -v32
v_fma_f32 v49, v49, s48, -v32
v_fma_f32 v50, v50, s48, -v32
v_fma_f32 v51, v51, s48, -v32
v_fma_f32 v52, v52, s48, -v32
v_fma_f32 v53, v53, s48, -v32
v_fma_f32 v54, v54, s48, -v32
v_fma_f32 v55, v55, s48, -v32
v_fma_f32 v56, v56, s48, -v32
v_fma_f32 v57, v57, s48, -v32
v_fma_f32 v58, v58, s48, -v32
v_fma_f32 v59, v59, s48, -v32
v_fma_f32 v60, v60, s48, -v32
v_fma_f32 v61, v61, s48, -v32
v_fma_f32 v62, v62, s48, -v32
v_fma_f32 v63, v63, s48, -v32
ds_write_b32 v8, v34
v_mul_f32 v29, v29, v34
v_exp_f32 v48, v48
v_exp_f32 v49, v49
v_exp_f32 v50, v50
v_exp_f32 v51, v51
v_exp_f32 v52, v52
v_exp_f32 v53, v53
v_exp_f32 v54, v54
v_exp_f32 v55, v55
v_exp_f32 v56, v56
v_exp_f32 v57, v57
v_exp_f32 v58, v58
v_exp_f32 v59, v59
v_exp_f32 v60, v60
v_exp_f32 v61, v61
v_exp_f32 v62, v62
v_exp_f32 v63, v63
v_add_u32 v8, 128, v8
v_cvt_pk_bf16_f32 v40, v48, v49
v_cvt_pk_bf16_f32 v41, v50, v51
v_cvt_pk_bf16_f32 v42, v52, v53
v_cvt_pk_bf16_f32 v43, v54, v55
v_cvt_pk_bf16_f32 v44, v56, v57
v_cvt_pk_bf16_f32 v45, v58, v59
v_cvt_pk_bf16_f32 v46, v60, v61
v_cvt_pk_bf16_f32 v47, v62, v63
v_add_f32 v30, v48, v49
v_add_f32 v31, v50, v51
v_add_f32 v30, v30, v52
v_add_f32 v31, v31, v53
v_add_f32 v30, v30, v54
v_add_f32 v31, v31, v55
v_add_f32 v30, v30, v56
v_add_f32 v31, v31, v57
v_add_f32 v30, v30, v58
v_add_f32 v31, v31, v59
v_add_f32 v30, v30, v60
v_add_f32 v31, v31, v61
v_add_f32 v30, v30, v62
v_add_f32 v31, v31, v63
v_add_f32 v30, v30, v31
v_add_f32 v29, v29, v30
s_set_gpr_idx_on s49, gpr_idx(DST)
s_nop 0
v_mov_b32 v128, v40
v_mov_b32 v129, v41
v_mov_b32 v130, v42
v_mov_b32 v131, v43
v_mov_b32 v132, v44
v_mov_b32 v133, v45
v_mov_b32 v134, v46
v_mov_b32 v135, v47
s_set_gpr_idx_off
s_add_u32 s49, s49, 8
s_cmp_eq_u32 s43, s42
s_cbranch_scc1 L_V0
L_X:
s_waitcnt lgkmcnt(0)
v_mfma_f32_32x32x16_bf16 v[48:63], v[96:99], v[64:67], 0
v_mfma_f32_32x32x16_bf16 v[48:63], v[100:103], v[68:71], v[48:63]
v_mfma_f32_32x32x16_bf16 v[48:63], v[104:107], v[72:75], v[48:63]
v_mfma_f32_32x32x16_bf16 v[48:63], v[108:111], v[76:79], v[48:63]
v_mfma_f32_32x32x16_bf16 v[48:63], v[112:115], v[80:83], v[48:63]
v_mfma_f32_32x32x16_bf16 v[48:63], v[116:119], v[84:87], v[48:63]
v_mfma_f32_32x32x16_bf16 v[48:63], v[120:123], v[88:91], v[48:63]
v_mfma_f32_32x32x16_bf16 v[48:63], v[124:127], v[92:95], v[48:63]
v_xor_b32 v16, s44, v16
v_xor_b32 v17, s44, v17
v_xor_b32 v18, s44, v18
v_xor_b32 v19, s44, v19
v_xor_b32 v20, s44, v20
v_xor_b32 v21, s44, v21
v_xor_b32 v22, s44, v22
v_xor_b32 v23, s44, v23
s_xor_b32 s44, s44, 0x10000
s_add_u32 s43, s43, 1
s_cmp_lg_u32 s43, 1
s_cbranch_scc1 L_nomask
s_nop 0
v_cmp_lt_i32 vcc, 0, v14
s_nop 1
v_cndmask_b32 v48, v15, v48, vcc
v_cmp_lt_i32 vcc, 1, v14
s_nop 1
v_cndmask_b32 v49, v15, v49, vcc
v_cmp_lt_i32 vcc, 2, v14
s_nop 1
v_cndmask_b32 v50, v15, v50, vcc
v_cmp_lt_i32 vcc, 3, v14
s_nop 1
v_cndmask_b32 v51, v15, v51, vcc
v_cmp_lt_i32 vcc, 8, v14
s_nop 1
v_cndmask_b32 v52, v15, v52, vcc
v_cmp_lt_i32 vcc, 9, v14
s_nop 1
v_cndmask_b32 v53, v15, v53, vcc
v_cmp_lt_i32 vcc, 10, v14
s_nop 1
v_cndmask_b32 v54, v15, v54, vcc
v_cmp_lt_i32 vcc, 11, v14
s_nop 1
v_cndmask_b32 v55, v15, v55, vcc
v_cmp_lt_i32 vcc, 16, v14
s_nop 1
v_cndmask_b32 v56, v15, v56, vcc
v_cmp_lt_i32 vcc, 17, v14
s_nop 1
v_cndmask_b32 v57, v15, v57, vcc
v_cmp_lt_i32 vcc, 18, v14
s_nop 1
v_cndmask_b32 v58, v15, v58, vcc
v_cmp_lt_i32 vcc, 19, v14
s_nop 1
v_cndmask_b32 v59, v15, v59, vcc
v_cmp_lt_i32 vcc, 24, v14
s_nop 1
v_cndmask_b32 v60, v15, v60, vcc
v_cmp_lt_i32 vcc, 25, v14
s_nop 1
v_cndmask_b32 v61, v15, v61, vcc
v_cmp_lt_i32 vcc, 26, v14
s_nop 1
v_cndmask_b32 v62, v15, v62, vcc
v_cmp_lt_i32 vcc, 27, v14
s_nop 1
v_cndmask_b32 v63, v15, v63, vcc
s_branch L_max
L_nomask:
s_cmp_lg_u32 s43, s42
s_cbranch_scc1 L_max
s_set_gpr_idx_on s50, gpr_idx(SRC0)
s_nop 0
v_mov_b32 v40, v128
v_mov_b32 v41, v129
v_mov_b32 v42, v130
v_mov_b32 v43, v131
v_mov_b32 v44, v132
v_mov_b32 v45, v133
v_mov_b32 v46, v134
v_mov_b32 v47, v135
s_set_gpr_idx_off
s_add_u32 s50, s50, 8
ds_write_b128 v4, v[40:43]
ds_write_b128 v4, v[44:47] offset:1024
v_xor_b32 v4, 0x2000, v4
L_max:
v_max3_f32 v30, v48, v49, v50
v_max3_f32 v31, v51, v52, v53
v_max3_f32 v30, v30, v54, v55
v_max3_f32 v31, v31, v56, v57
v_max3_f32 v30, v30, v58, v59
v_max3_f32 v31, v31, v60, v61
v_max3_f32 v30, v30, v62, v63
v_max_f32 v30, v30, v31
ds_write_b32 v6, v30
v_xor_b32 v6, 0x400, v6
s_waitcnt lgkmcnt(0)
s_barrier
s_branch L_K
L_V0:
v_or_b32 v6, 0x400, v6
v_or_b32 v7, 0x400, v7
ds_write_b32 v6, v29 offset:1024
v_add_u32 v7, 1024, v7
v_mov_b32 v48, 0
v_mov_b32 v49, 0
v_mov_b32 v50, 0
v_mov_b32 v51, 0
v_mov_b32 v52, 0
v_mov_b32 v53, 0
v_mov_b32 v54, 0
v_mov_b32 v55, 0
v_mov_b32 v56, 0
v_mov_b32 v57, 0
v_mov_b32 v58, 0
v_mov_b32 v59, 0
v_mov_b32 v60, 0
v_mov_b32 v61, 0
v_mov_b32 v62, 0
v_mov_b32 v63, 0
s_max_u32 s45, s42, 2
s_and_b32 s47, s45, 3
s_lshl_b32 s47, s47, 15
s_add_u32 s45, s45, 1
v_add_u32 v26, s47, v24
v_add_u32 v27, s47, v25
s_sub_u32 s42, s42, 1
s_cmp_lg_u32 s42, 0
s_waitcnt lgkmcnt(0)
s_cbranch_scc1 L_V
ds_write_b128 v4, v[40:43]
ds_write_b128 v4, v[44:47] offset:1024
s_waitcnt lgkmcnt(0)
s_barrier
s_branch L_last
L_V:
ds_read_b128 v[64:67], v5 offset:0
ds_read_b64_tr_b16 v[96:97], v26 offset:0
ds_read_b64_tr_b16 v[98:99], v27 offset:2048
ds_read_b128 v[68:71], v5 offset:1024
ds_read_b64_tr_b16 v[100:101], v26 offset:4096
ds_read_b64_tr_b16 v[102:103], v27 offset:6144
ds_read_b128 v[72:75], v5 offset:2048
ds_read_b64_tr_b16 v[104:105], v26 offset:8192
ds_read_b64_tr_b16 v[106:107], v27 offset:10240
ds_read_b128 v[76:79], v5 offset:3072
ds_read_b64_tr_b16 v[108:109], v26 offset:12288
ds_read_b64_tr_b16 v[110:111], v27 offset:14336
s_set_gpr_idx_on s50, gpr_idx(SRC0)
s_nop 0
v_mov_b32 v40, v128
v_mov_b32 v41, v129
v_mov_b32 v42, v130
v_mov_b32 v43, v131
v_mov_b32 v44, v132
v_mov_b32 v45, v133
v_mov_b32 v46, v134
v_mov_b32 v47, v135
s_set_gpr_idx_off
s_add_u32 s50, s50, 8
s_waitcnt lgkmcnt(9)
v_mfma_f32_32x32x16_bf16 v[48:63], v[96:99], v[64:67], v[48:63]
ds_read_b128 v[80:83], v5 offset:4096
ds_read_b64_tr_b16 v[112:113], v26 offset:16384
ds_read_b64_tr_b16 v[114:115], v27 offset:18432
s_waitcnt lgkmcnt(9)
v_mfma_f32_32x32x16_bf16 v[48:63], v[100:103], v[68:71], v[48:63]
ds_read_b128 v[84:87], v5 offset:5120
ds_read_b64_tr_b16 v[116:117], v26 offset:20480
ds_read_b64_tr_b16 v[118:119], v27 offset:22528
s_waitcnt lgkmcnt(9)
v_mfma_f32_32x32x16_bf16 v[48:63], v[104:107], v[72:75], v[48:63]
ds_read_b128 v[88:91], v5 offset:6144
ds_read_b64_tr_b16 v[120:121], v26 offset:24576
ds_read_b64_tr_b16 v[122:123], v27 offset:26624
s_waitcnt lgkmcnt(9)
v_mfma_f32_32x32x16_bf16 v[48:63], v[108:111], v[76:79], v[48:63]
ds_read_b128 v[92:95], v5 offset:7168
ds_read_b64_tr_b16 v[124:125], v26 offset:28672
ds_read_b64_tr_b16 v[126:127], v27 offset:30720
s_waitcnt lgkmcnt(9)
v_mfma_f32_32x32x16_bf16 v[48:63], v[112:115], v[80:83], v[48:63]
ds_read_b32 v34, v9
ds_write_b128 v4, v[40:43]
ds_write_b128 v4, v[44:47] offset:1024
s_waitcnt lgkmcnt(9)
v_mfma_f32_32x32x16_bf16 v[48:63], v[116:119], v[84:87], v[48:63]
s_waitcnt lgkmcnt(6)
v_mfma_f32_32x32x16_bf16 v[48:63], v[120:123], v[88:91], v[48:63]
s_waitcnt lgkmcnt(3)
v_mfma_f32_32x32x16_bf16 v[48:63], v[124:127], v[92:95], v[48:63]
v_xor_b32 v5, 0x2000, v5
v_xor_b32 v4, 0x2000, v4
v_add_u32 v9, 128, v9
s_and_b32 s47, s45, 3
s_lshl_b32 s47, s47, 15
s_add_u32 s45, s45, 1
v_add_u32 v26, s47, v24
v_add_u32 v27, s47, v25
s_sub_u32 s42, s42, 1
s_cmp_lg_u32 s42, 0
s_waitcnt lgkmcnt(0)
s_nop 0
v_pk_mul_f32 v[48:49], v[48:49], v[34:35] op_sel_hi:[1,0]
v_pk_mul_f32 v[50:51], v[50:51], v[34:35] op_sel_hi:[1,0]
v_pk_mul_f32 v[52:53], v[52:53], v[34:35] op_sel_hi:[1,0]
v_pk_mul_f32 v[54:55], v[54:55], v[34:35] op_sel_hi:[1,0]
v_pk_mul_f32 v[56:57], v[56:57], v[34:35] op_sel_hi:[1,0]
v_pk_mul_f32 v[58:59], v[58:59], v[34:35] op_sel_hi:[1,0]
v_pk_mul_f32 v[60:61], v[60:61], v[34:35] op_sel_hi:[1,0]
v_pk_mul_f32 v[62:63], v[62:63], v[34:35] op_sel_hi:[1,0]
s_barrier
s_cbranch_scc1 L_V
L_last:
ds_read_b128 v[64:67], v5 offset:0
ds_read_b64_tr_b16 v[96:97], v26 offset:0
ds_read_b64_tr_b16 v[98:99], v27 offset:2048
ds_read_b128 v[68:71], v5 offset:1024
ds_read_b64_tr_b16 v[100:101], v26 offset:4096
ds_read_b64_tr_b16 v[102:103], v27 offset:6144
ds_read_b128 v[72:75], v5 offset:2048
ds_read_b64_tr_b16 v[104:105], v26 offset:8192
ds_read_b64_tr_b16 v[106:107], v27 offset:10240
ds_read_b128 v[76:79], v5 offset:3072
ds_read_b64_tr_b16 v[108:109], v26 offset:12288
ds_read_b64_tr_b16 v[110:111], v27 offset:14336
s_waitcnt lgkmcnt(9)
v_mfma_f32_32x32x16_bf16 v[48:63], v[96:99], v[64:67], v[48:63]
ds_read_b128 v[80:83], v5 offset:4096
ds_read_b64_tr_b16 v[112:113], v26 offset:16384
ds_read_b64_tr_b16 v[114:115], v27 offset:18432
s_waitcnt lgkmcnt(9)
v_mfma_f32_32x32x16_bf16 v[48:63], v[100:103], v[68:71], v[48:63]
ds_read_b128 v[84:87], v5 offset:5120
ds_read_b64_tr_b16 v[116:117], v26 offset:20480
ds_read_b64_tr_b16 v[118:119], v27 offset:22528
s_waitcnt lgkmcnt(9)
v_mfma_f32_32x32x16_bf16 v[48:63], v[104:107], v[72:75], v[48:63]
ds_read_b128 v[88:91], v5 offset:6144
ds_read_b128 v[92:95], v5 offset:7168
ds_read_b128 v[40:43], v7
ds_read_b128 v[44:47], v7 offset:16
s_waitcnt lgkmcnt(10)
v_mfma_f32_32x32x16_bf16 v[48:63], v[108:111], v[76:79], v[48:63]
s_waitcnt lgkmcnt(7)
v_mfma_f32_32x32x16_bf16 v[48:63], v[112:115], v[80:83], v[48:63]
s_waitcnt lgkmcnt(4)
v_mfma_f32_32x32x16_bf16 v[48:63], v[116:119], v[84:87], v[48:63]
s_waitcnt lgkmcnt(0)
v_add_f32 v30, v40, v41
v_add_f32 v31, v42, v43
v_add_f32 v32, v44, v45
v_add_f32 v33, v46, v47
v_add_f32 v30, v30, v31
v_add_f32 v32, v32, v33
v_add_f32 v30, v30, v32
v_rcp_f32 v34, v30
v_add_u32 v31, 4096, v3
s_barrier
ds_read_b64_tr_b16 v[120:121], v26 offset:24576
ds_read_b64_tr_b16 v[122:123], v27 offset:26624
ds_read_b64_tr_b16 v[124:125], v26 offset:28672
ds_read_b64_tr_b16 v[126:127], v27 offset:30720
s_waitcnt lgkmcnt(2)
v_mfma_f32_32x32x16_bf16 v[48:63], v[120:123], v[88:91], v[48:63]
s_waitcnt lgkmcnt(0)
v_mfma_f32_32x32x16_bf16 v[48:63], v[124:127], v[92:95], v[48:63]
s_nop 11
v_pk_mul_f32 v[48:49], v[48:49], v[34:35] op_sel_hi:[1,0]
v_pk_mul_f32 v[50:51], v[50:51], v[34:35] op_sel_hi:[1,0]
v_cvt_pk_bf16_f32 v40, v48, v49
v_cvt_pk_bf16_f32 v41, v50, v51
ds_write_b64 v36, v[40:41]
v_pk_mul_f32 v[52:53], v[52:53], v[34:35] op_sel_hi:[1,0]
v_pk_mul_f32 v[54:55], v[54:55], v[34:35] op_sel_hi:[1,0]
v_cvt_pk_bf16_f32 v42, v52, v53
v_cvt_pk_bf16_f32 v43, v54, v55
ds_write_b64 v37, v[42:43]
v_pk_mul_f32 v[56:57], v[56:57], v[34:35] op_sel_hi:[1,0]
v_pk_mul_f32 v[58:59], v[58:59], v[34:35] op_sel_hi:[1,0]
v_cvt_pk_bf16_f32 v44, v56, v57
v_cvt_pk_bf16_f32 v45, v58, v59
ds_write_b64 v38, v[44:45]
v_pk_mul_f32 v[60:61], v[60:61], v[34:35] op_sel_hi:[1,0]
v_pk_mul_f32 v[62:63], v[62:63], v[34:35] op_sel_hi:[1,0]
v_cvt_pk_bf16_f32 v46, v60, v61
v_cvt_pk_bf16_f32 v47, v62, v63
ds_write_b64 v12, v[46:47]
ds_read_b128 v[96:99], v13
ds_read_b128 v[100:103], v13 offset:1024
s_waitcnt lgkmcnt(1)
global_store_dwordx4 v3, v[96:99], s[14:15]
s_waitcnt lgkmcnt(0)
global_store_dwordx4 v31, v[100:103], s[14:15]
L_end:
s_endpgm
.section .rodata,"a"
.p2align 6
.amdhsa_kernel standalone__paged_block_table_kv_pagedattention__sampling_kernel
  .amdhsa_next_free_vgpr 256
  .amdhsa_next_free_sgpr 72
  .amdhsa_accum_offset 256
  .amdhsa_group_segment_fixed_size 0
  .amdhsa_kernarg_size 64
  .amdhsa_user_sgpr_count 2
  .amdhsa_user_sgpr_kernarg_segment_ptr 1
  .amdhsa_system_sgpr_workgroup_id_x 1
.end_amdhsa_kernel
```
